```python
import torch

def _softmax(x, axis=-1):
    return torch.softmax(x, dim=axis)
def _gelu(x):
    return torch.nn.functional.gelu(x, approximate="tanh")
def _silu(x):
    return torch.nn.functional.silu(x)
def _sigmoid(x):
    return torch.sigmoid(x)
def _layernorm(x, axis=-1, eps=1e-5):
    m = x.mean(dim=axis, keepdim=True)
    v = x.var(dim=axis, keepdim=True, unbiased=False)
    return (x - m) / torch.sqrt(v + eps)
def _scatter_add(tgt, idx, src, axis=0):
    return tgt.clone().index_add_(axis, idx, src)
def _segment_sum(src, seg, n):
    out = torch.zeros((n,) + src.shape[1:], dtype=src.dtype)
    return out.index_add_(0, seg, src)
def _pad(x, pw):
    flat = tuple(v for pair in reversed(pw) for v in pair)
    return torch.nn.functional.pad(x, flat)

kernel_name = 'standalone__paged_block_table_kv_radixattention__sampling'

def setup_inputs():

    _w = (lambda a: (lambda t: t.to(torch.bfloat16) if t.is_floating_point() else t)(torch.as_tensor(a)))
    B, H, Hkv, Dh = 8, 32, 32, 128
    Lk = 2048
    bs = 16
    nb = max(2, Lk // bs)
    P = max(1, nb // 2)
    n_phys = P + B * (nb - P)
    shared = torch.arange(P, dtype=torch.int64)
    priv = P + torch.arange(B * (nb - P), dtype=torch.int64).reshape(B, nb - P)
    bt = torch.cat([torch.tile(shared[None, :], (B, 1)), priv], dim=1)
    ctx = nb * bs - (torch.arange(1, B + 1, dtype=torch.int64) * 2654435761) % max(1, (nb * bs - P * bs) // 2)
    return {
        "q": _w((lambda *s: torch.randn(*s, dtype=torch.bfloat16) * 0.8)(B, H, Dh)),
        "k_cache": _w((lambda *s: torch.randn(*s, dtype=torch.bfloat16) * 0.8)(n_phys, bs, Hkv, Dh)),
        "v_cache": _w((lambda *s: torch.randn(*s, dtype=torch.bfloat16) * 0.05)(n_phys, bs, Hkv, Dh)),
        "block_table": _w(bt.to(torch.int64)),
        "ctx_lens": _w(torch.as_tensor(ctx).to(torch.int64)),
    }

def reference(q, k_cache, v_cache, block_table, ctx_lens):
    B, H, Dh = q.shape
    n_phys, bs, Hkv, _ = k_cache.shape
    nb = block_table.shape[1]
    Lk = nb * bs
    rep = H // Hkv
    k = k_cache[block_table].reshape(B, Lk, Hkv, Dh)
    v = v_cache[block_table].reshape(B, Lk, Hkv, Dh)
    k = (lambda x, n, axis: torch.repeat_interleave(x, n, dim=axis))(k, rep, axis=2)
    v = (lambda x, n, axis: torch.repeat_interleave(x, n, dim=axis))(v, rep, axis=2)
    scores = torch.einsum("bhd,bkhd->bhk", q, k) * (Dh ** -0.5)
    pos = torch.arange(Lk)
    valid = pos[None, :] < ctx_lens[:, None]
    scores = torch.where(valid[:, None, :], scores, -1e9)
    p = _softmax(scores, axis=-1)
    return torch.einsum("bhk,bkhd->bhd", p, v)
```

```asm
; @launch grid=(256,1,1) block=(320,1,1) lds=98304
.amdgcn_target "amdgcn-amd-amdhsa--gfx950"
.text
.globl standalone__paged_block_table_kv_radixattention__sampling_kernel
.p2align 10
.fill 64, 4, 0xbf810000
.p2align 8
.type standalone__paged_block_table_kv_radixattention__sampling_kernel,@function
standalone__paged_block_table_kv_radixattention__sampling_kernel:
    v_lshrrev_b32 v2, 6, v0
    s_lshr_b32 s34, s2, 3
    v_readfirstlane_b32 s32, v2
    s_cmp_ge_u32 s34, 32
    s_cbranch_scc1 L_end
    s_getpc_b64 s[80:81]
L_pc:
    v_mov_b32 v33, 0
    s_cmp_lg_u32 s32, 0
    s_cbranch_scc1 L_nohinit
    v_mov_b64 v[8:9], 0
    v_mov_b64 v[10:11], 0
    ds_write_b128 v33, v[8:11] offset:0
    v_lshlrev_b32 v34, 7, v0
    global_load_dword v35, v34, s[80:81]
    s_waitcnt lgkmcnt(0)
L_nohinit:
    s_load_dwordx16 s[4:19], s[0:1], 0
    s_and_b32 s33, s34, 7
    s_and_b32 s70, s2, 7
    s_lshl_b32 s72, s34, 4
    s_lshr_b32 s71, s2, 7
    s_mul_i32 s71, s71, 18
    s_lshl_b32 s34, s70, 1
    s_xor_b32 s34, s34, s71
    s_bfe_u32 s71, s2, 0x10006
    s_or_b32 s34, s34, s71
    s_lshl_b32 s70, s70, 9
    s_add_u32 s3, s70, s72
    s_add_u32 s3, s3, L_table-L_pc
    v_and_b32 v1, 63, v0
    v_lshrrev_b32 v2, 4, v1
    v_and_b32 v3, 15, v1
    v_xor_b32 v42, v3, v2
    v_lshlrev_b32 v43, 13, v2
    v_lshl_add_u32 v4, v42, 4, v43
    v_xor_b32 v5, 64, v4
    v_add_u32 v5, 31744, v5
    s_cmp_eq_u32 s32, 0
    s_cbranch_scc1 L_helper
    v_xor_b32 v6, 128, v4
    v_add_u32 v6, 63488, v6
    v_xor_b32 v7, 192, v4
    v_add_u32 v7, 95232, v7
    s_mov_b32 s22, 75497472
    s_mov_b32 s23, 0x20000
    s_lshl_b32 s45, s32, 14
    s_add_u32 s45, s45, 16384
    s_add_u32 s70, s33, 1
    s_mul_i32 s70, s70, 433
    s_and_b32 s70, s70, 511
    s_sub_u32 s71, 1983, s70
    s_lshr_b32 s71, s71, 4
    s_add_u32 s71, s71, s32
    s_lshl_b32 s44, s71, 4
    s_lshl_b32 s72, s33, 6
    s_add_u32 s71, s71, s72
    s_lshl_b32 s71, s71, 17
    s_lshl_b32 s72, s34, 8
    s_add_u32 s43, s71, s72
    s_mov_b32 m0, s45
    s_mov_b32 s26, 75497472
    s_mov_b32 s27, 0x20000
    v_lshlrev_b32 v44, 1, v2
    v_xor_b32 v44, v3, v44
    v_lshl_add_u32 v8, v44, 4, v43
    v_xor_b32 v9, 128, v8
    v_add_u32 v10, 63488, v8
    v_add_u32 v11, 95232, v9
    v_add_u32 v9, 31744, v9
    s_barrier
    s_cmp_eq_u32 s32, 4
    s_cbranch_scc1 L_lastw
    s_waitcnt lgkmcnt(0)
    s_mov_b32 s20, s6
    s_and_b32 s21, s7, 0xffff
    buffer_load_dwordx4 v4, s[20:23], s43 offen offset:0 nt lds
    buffer_load_dwordx4 v5, s[20:23], s43 offen offset:1024 nt lds
    buffer_load_dwordx4 v6, s[20:23], s43 offen offset:2048 nt lds
    buffer_load_dwordx4 v7, s[20:23], s43 offen offset:3072 nt lds
    s_mov_b32 s24, s8
    s_and_b32 s25, s9, 0xffff
    s_add_u32 m0, s45, 4096
    s_load_dwordx4 s[28:31], s[80:81], s3
    buffer_load_dwordx4 v8, s[24:27], s43 offen offset:0 nt lds
    buffer_load_dwordx4 v9, s[24:27], s43 offen offset:1024 nt lds
    buffer_load_dwordx4 v10, s[24:27], s43 offen offset:2048 nt lds
    buffer_load_dwordx4 v11, s[24:27], s43 offen offset:3072 nt lds
    s_branch L_stream
L_lastw:
    s_add_u32 s70, s70, s44
    s_sub_u32 s70, 2048, s70
    v_sub_u32 v30, s70, v2
    v_bfrev_b32 v31, 2
    v_cmp_lt_i32 s[48:49], 0, v30
    v_cmp_lt_i32 s[50:51], 4, v30
    v_cmp_lt_i32 s[52:53], 8, v30
    v_cmp_lt_i32 s[54:55], 12, v30
    s_nop 0
    v_cndmask_b32 v80, v31, v4, s[48:49]
    v_cndmask_b32 v84, v31, v8, s[48:49]
    v_cndmask_b32 v81, v31, v5, s[50:51]
    v_cndmask_b32 v85, v31, v9, s[50:51]
    v_cndmask_b32 v82, v31, v6, s[52:53]
    v_cndmask_b32 v86, v31, v10, s[52:53]
    v_cndmask_b32 v83, v31, v7, s[54:55]
    v_cndmask_b32 v87, v31, v11, s[54:55]
    s_waitcnt lgkmcnt(0)
    s_mov_b32 s20, s6
    s_and_b32 s21, s7, 0xffff
    buffer_load_dwordx4 v80, s[20:23], s43 offen offset:0 nt lds
    buffer_load_dwordx4 v81, s[20:23], s43 offen offset:1024 nt lds
    buffer_load_dwordx4 v82, s[20:23], s43 offen offset:2048 nt lds
    buffer_load_dwordx4 v83, s[20:23], s43 offen offset:3072 nt lds
    s_mov_b32 s24, s8
    s_and_b32 s25, s9, 0xffff
    s_add_u32 m0, s45, 4096
    s_load_dwordx4 s[28:31], s[80:81], s3
    buffer_load_dwordx4 v84, s[24:27], s43 offen offset:0 nt lds
    buffer_load_dwordx4 v85, s[24:27], s43 offen offset:1024 nt lds
    buffer_load_dwordx4 v86, s[24:27], s43 offen offset:2048 nt lds
    buffer_load_dwordx4 v87, s[24:27], s43 offen offset:3072 nt lds
    s_branch L_stream
L_helper:
    s_memrealtime s[76:77]
    v_and_b32 v7, 7, v1
    v_lshlrev_b32 v24, 2, v7
    s_lshl_b32 s73, s34, 8
    v_add_u32 v26, s73, v4
    v_add_u32 v27, s73, v5
    s_mov_b32 m0, 2304
    s_barrier
    s_waitcnt lgkmcnt(0)
    global_load_lds_dwordx4 v26, s[4:5] nt
    global_load_lds_dwordx4 v27, s[4:5] offset:1024 nt
    s_load_dwordx4 s[28:31], s[80:81], s3
    s_cmp_lg_u32 s2, 0
    s_cbranch_scc1 L_hnotag
    s_getreg_b32 s79, hwreg(HW_REG_XCC_ID, 0, 3)
    s_andn2_b32 s75, s76, 15
    s_or_b32 s75, s75, s79
    s_or_b32 s75, s75, 8
    v_mov_b32 v34, s75
    s_mov_b64 exec, 1
    global_store_dword v33, v34, s[16:17] sc1
    s_mov_b64 exec, -1
L_hnotag:
    s_waitcnt lgkmcnt(0)
    s_bfe_u32 s39, s31, 0x50003
    s_cmp_eq_u32 s39, s34
    s_cbranch_scc1 L_hq1
    s_lshl_b32 s72, s39, 8
    s_mov_b32 m0, 256
    v_add_u32 v26, s72, v4
    v_add_u32 v27, s72, v5
    global_load_lds_dwordx4 v26, s[4:5] nt
    global_load_lds_dwordx4 v27, s[4:5] offset:1024 nt
    v_mov_b32 v30, 1
    s_waitcnt vmcnt(2)
    ds_write_b32 v33, v30 offset:12
L_hq1:
    v_mov_b32 v30, 2
    s_waitcnt vmcnt(0)
    ds_write_b32 v33, v30 offset:12
    v_lshlrev_b32 v4, 4, v1
    global_load_dwordx4 v[8:11], v4, s[10:11] offset:0
    global_load_dwordx4 v[12:15], v4, s[10:11] offset:1024
    global_load_dwordx4 v[16:19], v4, s[10:11] offset:2048
    global_load_dwordx4 v[20:23], v4, s[10:11] offset:3072
    global_load_dword v6, v24, s[12:13]
    global_load_dword v34, v33, s[16:17] sc1
    s_branch L_helper2
L_stream:
    s_sub_u32 s35, s32, 1
    s_mov_b32 s47, 0xf149f2ca
    s_mov_b32 s46, 0x3e0293ee
    v_lshlrev_b32 v12, 4, v42
    v_lshl_add_u32 v12, v3, 8, v12
    v_add_u32 v12, s45, v12
    v_xor_b32 v13, 64, v12
    v_xor_b32 v14, 128, v12
    v_xor_b32 v15, 192, v12
    v_lshrrev_b32 v42, 2, v1
    v_and_b32 v43, 7, v42
    v_and_b32 v44, 3, v1
    v_lshlrev_b32 v16, 8, v42
    v_lshl_add_u32 v16, v43, 5, v16
    v_lshl_add_u32 v16, v44, 3, v16
    s_add_u32 s70, s45, 4096
    v_add_u32 v16, s70, v16
    v_xor_b32 v17, 32, v16
    v_xor_b32 v18, 64, v16
    v_xor_b32 v19, 96, v16
    v_xor_b32 v20, 128, v16
    v_xor_b32 v21, 160, v16
    v_xor_b32 v22, 192, v16
    v_xor_b32 v23, 224, v16
    v_mov_b32 v28, s47
    v_mov_b32 v29, 0
    v_mov_b64 v[112:113], 0
    v_mov_b64 v[114:115], 0
    v_mov_b64 v[116:117], 0
    v_mov_b64 v[118:119], 0
    v_mov_b64 v[120:121], 0
    v_mov_b64 v[122:123], 0
    v_mov_b64 v[124:125], 0
    v_mov_b64 v[126:127], 0
    v_mov_b64 v[128:129], 0
    v_mov_b64 v[130:131], 0
    v_mov_b64 v[132:133], 0
    v_mov_b64 v[134:135], 0
    v_mov_b64 v[136:137], 0
    v_mov_b64 v[138:139], 0
    v_mov_b64 v[140:141], 0
    v_mov_b64 v[142:143], 0
    v_and_b32 v40, 7, v1
    v_add_u32 v27, 1, v40
    v_mul_u32_u24 v27, 433, v27
    v_and_b32 v27, 511, v27
    v_lshl_add_u32 v27, v2, 2, v27
    v_sub_u32 v27, 2048, v27
    s_mov_b32 s41, 0
    s_mov_b32 s42, 1
    v_mov_b32 v26, v27
    v_cmp_eq_u32 s[98:99], s33, v3
    s_mul_i32 s70, s35, 528
    v_lshl_add_u32 v182, v2, 4, s70
    v_mov_b32 v183, s70
    s_mov_b64 s[96:97], s[98:99]
    s_sub_u32 s70, s35, 4
    v_mov_b32 v31, s70
    v_mad_u32_u24 v32, v1, 4, v31
    s_waitcnt lgkmcnt(0)
    s_and_b32 s36, s30, 31
    s_bfe_u32 s38, s30, 0x70005
    s_bfe_u32 s37, s30, 0x4000c
    s_bfe_u32 s71, s30, 0x70010
    s_lshr_b32 s72, s30, 23
    s_bfe_u32 s39, s31, 0x50003
    v_mov_b32 v43, s29
    v_mov_b32 v44, s28
    v_cmp_gt_u32 s[48:49], s38, v32
    v_cmp_gt_u32 vcc, s36, v32
    v_mov_b32 v45, s72
    v_mov_b32 v46, s71
    v_cndmask_b32 v43, v43, v44, vcc
    v_cndmask_b32 v45, v45, v46, vcc
    s_bcnt1_i32_b64 s69, s[48:49]
    s_bcnt1_i32_b64 s68, vcc
    v_lshl_add_u32 v24, v32, 17, v43
    v_add_lshl_u32 v25, v32, v45, 4
    s_add_u32 s69, s69, 1
    s_add_u32 s83, s68, 1
    v_readlane_b32 s43, v24, 1
    s_cmp_eq_u32 s68, 0
    s_cselect_b32 s83, -1, s83
    s_cselect_b32 s82, -1, 1
    v_cmp_eq_u32 vcc, s37, v40
    s_cmp_eq_u32 s37, 8
    s_cselect_b64 vcc, -1, vcc
    v_and_b32 v45, 7, v1
    v_xor_b32 v46, v45, v2
    v_lshlrev_b32 v46, 4, v46
    v_lshl_add_u32 v46, v45, 8, v46
    v_xor_b32 v42, 64, v46
    v_xor_b32 v43, 128, v46
    v_xor_b32 v44, 192, v46
    v_cndmask_b32 v178, -16, v27, vcc
    s_sub_u32 s74, s69, 5
    s_cmp_eq_u32 s35, 0
    s_cselect_b32 s74, s74, -1
    s_xor_b32 s45, s45, 8192
    s_mov_b32 m0, s45
    s_waitcnt vmcnt(4)
    buffer_load_dwordx4 v4, s[20:23], s43 offen offset:0 nt lds
    buffer_load_dwordx4 v5, s[20:23], s43 offen offset:1024 nt lds
    buffer_load_dwordx4 v6, s[20:23], s43 offen offset:2048 nt lds
    buffer_load_dwordx4 v7, s[20:23], s43 offen offset:3072 nt lds
    s_add_u32 m0, s45, 4096
    s_nop 0
    buffer_load_dwordx4 v8, s[24:27], s43 offen offset:0 nt lds
    buffer_load_dwordx4 v9, s[24:27], s43 offen offset:1024 nt lds
    buffer_load_dwordx4 v10, s[24:27], s43 offen offset:2048 nt lds
    buffer_load_dwordx4 v11, s[24:27], s43 offen offset:3072 nt lds
L_qwait:
    ds_read_b32 v31, v33 offset:12
    s_waitcnt lgkmcnt(0)
    v_readfirstlane_b32 s70, v31
    s_nop 0
    s_cmp_eq_u32 s70, 0
    s_cbranch_scc1 L_qwait
    ds_read_b128 v[64:67], v46 offset:2304
    ds_read_b128 v[68:71], v42 offset:2304
    ds_read_b128 v[72:75], v43 offset:2304
    ds_read_b128 v[76:79], v44 offset:2304
    ds_read_b128 v[48:51], v46 offset:2304
    ds_read_b128 v[52:55], v42 offset:2304
    ds_read_b128 v[56:59], v43 offset:2304
    ds_read_b128 v[60:63], v44 offset:2304
    ds_read_b128 v[80:83], v12
    ds_read_b128 v[84:87], v13
    ds_read_b128 v[88:91], v14
    ds_read_b128 v[92:95], v15
    s_branch L_nonext
L_tile:
    s_add_u32 s42, s41, 1
    v_readlane_b32 s44, v25, s41
    v_readlane_b32 s43, v24, s42
    s_xor_b32 s45, s45, 8192
    s_mov_b32 m0, s45
    s_waitcnt vmcnt(4)
    ds_read_b128 v[80:83], v12
    ds_read_b128 v[84:87], v13
    ds_read_b128 v[88:91], v14
    ds_read_b128 v[92:95], v15
    s_cmp_lt_u32 s42, s69
    s_cbranch_scc0 L_nonext
    buffer_load_dwordx4 v4, s[20:23], s43 offen offset:0 nt lds
    buffer_load_dwordx4 v5, s[20:23], s43 offen offset:1024 nt lds
    buffer_load_dwordx4 v6, s[20:23], s43 offen offset:2048 nt lds
    buffer_load_dwordx4 v7, s[20:23], s43 offen offset:3072 nt lds
    s_add_u32 m0, s45, 4096
    s_nop 0
    buffer_load_dwordx4 v8, s[24:27], s43 offen offset:0 nt lds
    buffer_load_dwordx4 v9, s[24:27], s43 offen offset:1024 nt lds
    buffer_load_dwordx4 v10, s[24:27], s43 offen offset:2048 nt lds
    buffer_load_dwordx4 v11, s[24:27], s43 offen offset:3072 nt lds
L_nonext:
    v_subrev_u32 v30, s44, v26
    s_waitcnt lgkmcnt(3)
    v_mfma_f32_16x16x32_bf16 v[36:39], v[80:83], v[48:51], 0
    s_waitcnt lgkmcnt(2)
    v_mfma_f32_16x16x32_bf16 v[36:39], v[84:87], v[52:55], v[36:39]
    s_waitcnt lgkmcnt(1)
    v_mfma_f32_16x16x32_bf16 v[36:39], v[88:91], v[56:59], v[36:39]
    s_waitcnt lgkmcnt(0)
    v_mfma_f32_16x16x32_bf16 v[36:39], v[92:95], v[60:63], v[36:39]
    v_cmp_lt_i32 s[48:49], 0, v30
    v_cmp_lt_i32 s[50:51], 1, v30
    v_cmp_lt_i32 s[52:53], 2, v30
    v_cmp_lt_i32 s[54:55], 3, v30
    s_cmp_lt_u32 s42, s69
    s_cbranch_scc1 L_vwait
    s_waitcnt vmcnt(0)
L_vwait:
    s_waitcnt vmcnt(8)
    ds_read_b64_tr_b16 v[96:97], v16
    ds_read_b64_tr_b16 v[98:99], v17
    ds_read_b64_tr_b16 v[100:101], v18
    ds_read_b64_tr_b16 v[102:103], v19
    ds_read_b64_tr_b16 v[104:105], v20
    ds_read_b64_tr_b16 v[106:107], v21
    ds_read_b64_tr_b16 v[108:109], v22
    ds_read_b64_tr_b16 v[110:111], v23
    v_mov_b32 v42, s47
    v_mul_f32 v36, s46, v36
    v_mul_f32 v37, s46, v37
    v_mul_f32 v38, s46, v38
    v_mul_f32 v39, s46, v39
    v_cndmask_b32 v36, v42, v36, s[48:49]
    v_cndmask_b32 v37, v42, v37, s[50:51]
    v_cndmask_b32 v38, v42, v38, s[52:53]
    v_cndmask_b32 v39, v42, v39, s[54:55]
    v_max3_f32 v31, v36, v37, v38
    v_max3_f32 v31, v31, v39, v28
    v_mov_b32 v32, v31
    s_nop 1
    v_permlane32_swap_b32 v31, v32
    v_max_f32 v31, v31, v32
    v_mov_b32 v32, v31
    s_nop 1
    v_permlane16_swap_b32 v31, v32
    v_max_f32 v31, v31, v32
    v_sub_f32 v34, v28, v31
    v_sub_f32 v36, v36, v31
    v_sub_f32 v37, v37, v31
    v_sub_f32 v38, v38, v31
    v_sub_f32 v39, v39, v31
    v_cmp_neq_f32 vcc, v28, v31
    v_exp_f32 v34, v34
    v_exp_f32 v36, v36
    v_exp_f32 v37, v37
    v_exp_f32 v38, v38
    v_exp_f32 v39, v39
    v_mov_b32 v28, v31
    v_add_f32 v42, v36, v37
    v_add_f32 v43, v38, v39
    v_cvt_pk_bf16_f32 v40, v36, v37
    v_cvt_pk_bf16_f32 v41, v38, v39
    v_add_f32 v42, v42, v43
    s_and_b64 vcc, vcc, s[96:97]
    v_fma_f32 v29, v29, v34, v42
    s_cbranch_vccz L_noscale
    v_pk_mul_f32 v[112:113], v[112:113], v[34:35] op_sel_hi:[1,0]
    v_pk_mul_f32 v[114:115], v[114:115], v[34:35] op_sel_hi:[1,0]
    v_pk_mul_f32 v[116:117], v[116:117], v[34:35] op_sel_hi:[1,0]
    v_pk_mul_f32 v[118:119], v[118:119], v[34:35] op_sel_hi:[1,0]
    v_pk_mul_f32 v[120:121], v[120:121], v[34:35] op_sel_hi:[1,0]
    v_pk_mul_f32 v[122:123], v[122:123], v[34:35] op_sel_hi:[1,0]
    v_pk_mul_f32 v[124:125], v[124:125], v[34:35] op_sel_hi:[1,0]
    v_pk_mul_f32 v[126:127], v[126:127], v[34:35] op_sel_hi:[1,0]
    v_pk_mul_f32 v[128:129], v[128:129], v[34:35] op_sel_hi:[1,0]
    v_pk_mul_f32 v[130:131], v[130:131], v[34:35] op_sel_hi:[1,0]
    v_pk_mul_f32 v[132:133], v[132:133], v[34:35] op_sel_hi:[1,0]
    v_pk_mul_f32 v[134:135], v[134:135], v[34:35] op_sel_hi:[1,0]
    v_pk_mul_f32 v[136:137], v[136:137], v[34:35] op_sel_hi:[1,0]
    v_pk_mul_f32 v[138:139], v[138:139], v[34:35] op_sel_hi:[1,0]
    v_pk_mul_f32 v[140:141], v[140:141], v[34:35] op_sel_hi:[1,0]
    v_pk_mul_f32 v[142:143], v[142:143], v[34:35] op_sel_hi:[1,0]
    s_nop 0
L_noscale:
    s_waitcnt lgkmcnt(7)
    v_mfma_f32_16x16x16_bf16 v[112:115], v[96:97], v[40:41], v[112:115]
    v_mov_b32 v185, v29
    v_mov_b32 v32, v29
    s_waitcnt lgkmcnt(6)
    v_mfma_f32_16x16x16_bf16 v[116:119], v[98:99], v[40:41], v[116:119]
    v_mov_b32 v184, v28
    s_waitcnt lgkmcnt(5)
    v_mfma_f32_16x16x16_bf16 v[120:123], v[100:101], v[40:41], v[120:123]
    v_permlane32_swap_b32 v185, v32
    s_waitcnt lgkmcnt(4)
    v_mfma_f32_16x16x16_bf16 v[124:127], v[102:103], v[40:41], v[124:127]
    v_add_f32 v185, v185, v32
    v_mov_b32 v32, v185
    s_waitcnt lgkmcnt(3)
    v_mfma_f32_16x16x16_bf16 v[128:131], v[104:105], v[40:41], v[128:131]
    s_waitcnt lgkmcnt(2)
    v_mfma_f32_16x16x16_bf16 v[132:135], v[106:107], v[40:41], v[132:135]
    v_permlane16_swap_b32 v185, v32
    s_waitcnt lgkmcnt(1)
    v_mfma_f32_16x16x16_bf16 v[136:139], v[108:109], v[40:41], v[136:139]
    v_add_f32 v185, v185, v32
    s_waitcnt lgkmcnt(0)
    v_mfma_f32_16x16x16_bf16 v[140:143], v[110:111], v[40:41], v[140:143]
    s_mov_b32 s41, s42
    s_cmp_lt_u32 s42, s69
    s_cbranch_scc1 L_more
L_final:
    s_mov_b64 exec, s[98:99]
    ds_write_b64 v183, v[184:185] offset:4864
    ds_write_b128 v182, v[112:115] offset:4352
    ds_write_b128 v182, v[116:119] offset:4416
    ds_write_b128 v182, v[120:123] offset:4480
    ds_write_b128 v182, v[124:127] offset:4544
    ds_write_b128 v182, v[128:131] offset:4608
    ds_write_b128 v182, v[132:135] offset:4672
    ds_write_b128 v182, v[136:139] offset:4736
    ds_write_b128 v182, v[140:143] offset:4800
    s_waitcnt lgkmcnt(0)
    s_barrier
    s_endpgm
L_more:
    v_xor_b32 v12, 0x2000, v12
    v_xor_b32 v13, 0x2000, v13
    v_xor_b32 v14, 0x2000, v14
    v_xor_b32 v15, 0x2000, v15
    v_xor_b32 v16, 0x2000, v16
    v_xor_b32 v17, 0x2000, v17
    v_xor_b32 v18, 0x2000, v18
    v_xor_b32 v19, 0x2000, v19
    v_xor_b32 v20, 0x2000, v20
    v_xor_b32 v21, 0x2000, v21
    v_xor_b32 v22, 0x2000, v22
    v_xor_b32 v23, 0x2000, v23
    s_cmp_eq_u32 s42, s82
    s_cbranch_scc1 L_stash
    s_cmp_eq_u32 s42, 6
    s_cbranch_scc1 L_verdict
L_back0:
    s_cmp_eq_u32 s42, s74
    s_cbranch_scc1 L_trig
L_back1:
    s_cmp_eq_u32 s42, s83
    s_cbranch_scc0 L_tile
    s_mul_i32 s70, s35, 4224
    s_add_u32 s70, s70, 6720
    v_mul_u32_u24 v42, 528, v3
    v_lshl_add_u32 v42, v2, 4, v42
    v_add_u32 v42, s70, v42
    s_lshl_b32 s70, s35, 6
    v_lshl_add_u32 v43, v3, 3, s70
    s_mov_b32 exec_lo, 0x00ff00ff
    s_mov_b32 exec_hi, 0x00ff00ff
    ds_write_b128 v42, v[112:115] offset:0
    ds_write_b128 v42, v[116:119] offset:64
    ds_write_b128 v42, v[120:123] offset:128
    ds_write_b128 v42, v[124:127] offset:192
    ds_write_b128 v42, v[128:131] offset:256
    ds_write_b128 v42, v[132:135] offset:320
    ds_write_b128 v42, v[136:139] offset:384
    ds_write_b128 v42, v[140:143] offset:448
    ds_write_b64 v43, v[184:185] offset:6464
    s_mov_b64 exec, 1
    v_mov_b32 v44, 1
    s_waitcnt lgkmcnt(0)
    ds_add_u32 v33, v44 offset:4
    s_mov_b64 exec, -1
    v_mov_b64 v[112:113], v[144:145]
    v_mov_b64 v[114:115], v[146:147]
    v_mov_b64 v[116:117], v[148:149]
    v_mov_b64 v[118:119], v[150:151]
    v_mov_b64 v[120:121], v[152:153]
    v_mov_b64 v[122:123], v[154:155]
    v_mov_b64 v[124:125], v[156:157]
    v_mov_b64 v[126:127], v[158:159]
    v_mov_b64 v[128:129], v[160:161]
    v_mov_b64 v[130:131], v[162:163]
    v_mov_b64 v[132:133], v[164:165]
    v_mov_b64 v[134:135], v[166:167]
    v_mov_b64 v[136:137], v[168:169]
    v_mov_b64 v[138:139], v[170:171]
    v_mov_b64 v[140:141], v[172:173]
    v_mov_b64 v[142:143], v[174:175]
    v_mov_b64 v[28:29], v[176:177]
    v_mov_b64 v[48:49], v[64:65]
    v_mov_b64 v[50:51], v[66:67]
    v_mov_b64 v[52:53], v[68:69]
    v_mov_b64 v[54:55], v[70:71]
    v_mov_b64 v[56:57], v[72:73]
    v_mov_b64 v[58:59], v[74:75]
    v_mov_b64 v[60:61], v[76:77]
    v_mov_b64 v[62:63], v[78:79]
    v_mov_b32 v26, v27
    s_mov_b64 s[96:97], s[98:99]
    s_waitcnt lgkmcnt(0)
    s_branch L_tile
L_stash:
    v_mov_b64 v[144:145], v[112:113]
    v_mov_b64 v[146:147], v[114:115]
    v_mov_b64 v[148:149], v[116:117]
    v_mov_b64 v[150:151], v[118:119]
    v_mov_b64 v[152:153], v[120:121]
    v_mov_b64 v[154:155], v[122:123]
    v_mov_b64 v[156:157], v[124:125]
    v_mov_b64 v[158:159], v[126:127]
    v_mov_b64 v[160:161], v[128:129]
    v_mov_b64 v[162:163], v[130:131]
    v_mov_b64 v[164:165], v[132:133]
    v_mov_b64 v[166:167], v[134:135]
    v_mov_b64 v[168:169], v[136:137]
    v_mov_b64 v[170:171], v[138:139]
    v_mov_b64 v[172:173], v[140:141]
    v_mov_b64 v[174:175], v[142:143]
    v_mov_b64 v[176:177], v[28:29]
    v_mov_b32 v28, s47
    v_mov_b32 v29, 0
    v_mov_b64 v[112:113], 0
    v_mov_b64 v[114:115], 0
    v_mov_b64 v[116:117], 0
    v_mov_b64 v[118:119], 0
    v_mov_b64 v[120:121], 0
    v_mov_b64 v[122:123], 0
    v_mov_b64 v[124:125], 0
    v_mov_b64 v[126:127], 0
    v_mov_b64 v[128:129], 0
    v_mov_b64 v[130:131], 0
    v_mov_b64 v[132:133], 0
    v_mov_b64 v[134:135], 0
    v_mov_b64 v[136:137], 0
    v_mov_b64 v[138:139], 0
    v_mov_b64 v[140:141], 0
    v_mov_b64 v[142:143], 0
    v_mov_b32 v26, v178
    s_mov_b64 s[96:97], -1
    s_cmp_eq_u32 s39, s34
    s_cbranch_scc1 L_tile
    v_and_b32 v45, 7, v1
    v_xor_b32 v46, v45, v2
    v_lshlrev_b32 v46, 4, v46
    v_lshl_add_u32 v46, v45, 8, v46
    v_xor_b32 v42, 64, v46
    v_xor_b32 v43, 128, v46
    v_xor_b32 v44, 192, v46
L_qwait2:
    ds_read_b32 v31, v33 offset:12
    s_waitcnt lgkmcnt(0)
    v_readfirstlane_b32 s70, v31
    s_nop 0
    s_cmp_lg_u32 s70, 2
    s_cbranch_scc1 L_qwait2
    ds_read_b128 v[48:51], v46 offset:256
    ds_read_b128 v[52:55], v42 offset:256
    ds_read_b128 v[56:59], v43 offset:256
    ds_read_b128 v[60:63], v44 offset:256
    s_waitcnt lgkmcnt(0)
    s_branch L_tile
L_trig:
    s_sub_u32 s70, s69, 3
    s_cmp_eq_u32 s74, s70
    s_cselect_b32 s71, 2, 1
    s_mov_b32 s74, s70
    v_mov_b32 v44, s71
    ds_write_b32 v33, v44 offset:8
    s_waitcnt lgkmcnt(0)
    s_branch L_back1
L_verdict:
    ds_read_b32 v42, v33 offset:0
    s_waitcnt lgkmcnt(0)
    v_readfirstlane_b32 s70, v42
    s_nop 0
    s_cmp_eq_u32 s70, 1
    s_cbranch_scc1 L_back0
    s_cmp_eq_u32 s70, 0
    s_cbranch_scc1 L_verdict
    s_cmp_eq_u32 s70, 3
    s_cbranch_scc1 L_alone
    s_branch L_general
L_helper2:
    s_and_b32 s36, s30, 31
    s_bfe_u32 s37, s30, 0x4000c
    s_bfe_u32 s40, s31, 0x40018
    s_mov_b32 s47, 0xf149f2ca
    v_add_u32 v7, 1, v7
    v_mul_u32_u24 v7, 433, v7
    v_and_b32 v7, 511, v7
    v_sub_u32 v7, 2048, v7
    v_and_b32 v5, 31, v1
    v_lshlrev_b32 v5, 2, v5
    v_bfe_u32 v25, v1, 4, 1
    v_lshrrev_b32 v26, 5, v1
    v_and_b32 v26, v26, v25
    v_lshl_add_u32 v5, v26, 6, v5
    v_lshlrev_b32 v25, 7, v25
    s_waitcnt vmcnt(0)
    v_xor_b32 v27, v6, v7
    v_sub_u32 v8, v8, v5
    v_sub_u32 v9, v9, v5
    v_sub_u32 v10, v10, v5
    v_sub_u32 v11, v11, v5
    v_xor_b32 v9, 1, v9
    v_xor_b32 v10, 2, v10
    v_xor_b32 v11, 3, v11
    v_or3_b32 v27, v27, v8, v9
    v_or3_b32 v27, v27, v10, v11
    v_add_u32 v5, v5, v25
    v_sub_u32 v12, v12, v5
    v_sub_u32 v13, v13, v5
    v_sub_u32 v14, v14, v5
    v_sub_u32 v15, v15, v5
    v_xor_b32 v13, 1, v13
    v_xor_b32 v14, 2, v14
    v_xor_b32 v15, 3, v15
    v_or3_b32 v27, v27, v12, v13
    v_or3_b32 v27, v27, v14, v15
    v_add_u32 v5, v5, v25
    v_sub_u32 v16, v16, v5
    v_sub_u32 v17, v17, v5
    v_sub_u32 v18, v18, v5
    v_sub_u32 v19, v19, v5
    v_xor_b32 v17, 1, v17
    v_xor_b32 v18, 2, v18
    v_xor_b32 v19, 3, v19
    v_or3_b32 v27, v27, v16, v17
    v_or3_b32 v27, v27, v18, v19
    v_add_u32 v5, v5, v25
    v_sub_u32 v20, v20, v5
    v_sub_u32 v21, v21, v5
    v_sub_u32 v22, v22, v5
    v_sub_u32 v23, v23, v5
    v_xor_b32 v21, 1, v21
    v_xor_b32 v22, 2, v22
    v_xor_b32 v23, 3, v23
    v_or3_b32 v27, v27, v20, v21
    v_or3_b32 v27, v27, v22, v23
    v_cmp_ne_u32 vcc, 0, v27
    ds_write_b32 v24, v6 offset:32
    s_cmp_lg_u64 vcc, 0
    s_cselect_b32 s70, 2, 1
    v_mov_b32 v26, s70
    s_waitcnt lgkmcnt(0)
    v_mov_b32 v28, s47
    v_mov_b32 v29, 0
    v_mov_b64 v[40:41], 0
    v_mov_b64 v[42:43], 0
    s_cmp_eq_u32 s70, 1
    s_cbranch_scc1 L_hfast0
    ds_write_b32 v33, v26 offset:0
    s_waitcnt lgkmcnt(0)
    s_barrier
    s_branch L_hfinal
L_hfast0:
L_hfast:
    v_readfirstlane_b32 s75, v34
    s_nop 0
    s_cmp_lg_u32 s75, 0
    s_cbranch_scc1 L_htag
L_hpolltag:
    global_load_dword v34, v33, s[16:17] sc1
    s_waitcnt vmcnt(0)
    v_readfirstlane_b32 s75, v34
    s_nop 0
    s_cmp_eq_u32 s75, 0
    s_cbranch_scc1 L_hpolltag
L_htag:
    s_bfe_u32 s84, s75, 0x80000
    s_bfe_u32 s85, s75, 0x80008
    s_bfe_u32 s86, s75, 0x80010
    s_bfe_u32 s87, s75, 0x80018
    s_getreg_b32 s79, hwreg(HW_REG_XCC_ID, 0, 4)
    s_add_u32 s72, s2, s75
    s_and_b32 s72, s72, 7
    s_cmp_eq_u32 s72, s79
    s_cselect_b32 s79, s31, 0
    s_cselect_b32 s40, s40, 0
    s_cselect_b32 s72, 1, 3
    v_mov_b32 v26, s72
    ds_write_b32 v33, v26 offset:0
    s_cmp_eq_u32 s36, 0
    s_cbranch_scc1 L_hgather
    s_min_u32 s71, s36, 4
L_hpoll:
    ds_read_b32 v6, v33 offset:4
    s_waitcnt lgkmcnt(0)
    v_readfirstlane_b32 s72, v6
    s_nop 0
    s_cmp_lt_u32 s72, s71
    s_cbranch_scc1 L_hpoll
    v_lshrrev_b32 v7, 3, v1
    v_and_b32 v5, 7, v1
    v_lshlrev_b32 v24, 3, v7
    v_mul_u32_u24 v25, 528, v7
    v_lshl_add_u32 v25, v5, 4, v25
    v_mov_b32 v26, v24
    s_mov_b32 s72, 0
L_hm1:
    ds_read_b32 v27, v26 offset:6464
    v_add_u32 v26, 64, v26
    s_add_u32 s72, s72, 1
    s_cmp_lt_u32 s72, s71
    s_waitcnt lgkmcnt(0)
    v_max_f32 v28, v28, v27
    s_cbranch_scc1 L_hm1
    v_mov_b64 v[44:45], 0
    v_mov_b64 v[46:47], 0
    v_mov_b64 v[48:49], 0
    v_mov_b64 v[50:51], 0
    v_mov_b64 v[52:53], 0
    v_mov_b64 v[54:55], 0
    s_mov_b32 s72, 0
L_hm2:
    ds_read_b64 v[72:73], v24 offset:6464
    ds_read_b128 v[56:59], v25 offset:6720
    ds_read_b128 v[60:63], v25 offset:6848
    ds_read_b128 v[64:67], v25 offset:6976
    ds_read_b128 v[68:71], v25 offset:7104
    v_add_u32 v24, 64, v24
    v_add_u32 v25, 4224, v25
    s_add_u32 s72, s72, 1
    s_cmp_lt_u32 s72, s71
    s_waitcnt lgkmcnt(4)
    v_sub_f32 v30, v72, v28
    v_exp_f32 v30, v30
    s_waitcnt lgkmcnt(0)
    v_fma_f32 v29, v30, v73, v29
    v_pk_fma_f32 v[40:41], v[56:57], v[30:31], v[40:41] op_sel_hi:[1,0,1]
    v_pk_fma_f32 v[42:43], v[58:59], v[30:31], v[42:43] op_sel_hi:[1,0,1]
    v_pk_fma_f32 v[44:45], v[60:61], v[30:31], v[44:45] op_sel_hi:[1,0,1]
    v_pk_fma_f32 v[46:47], v[62:63], v[30:31], v[46:47] op_sel_hi:[1,0,1]
    v_pk_fma_f32 v[48:49], v[64:65], v[30:31], v[48:49] op_sel_hi:[1,0,1]
    v_pk_fma_f32 v[50:51], v[66:67], v[30:31], v[50:51] op_sel_hi:[1,0,1]
    v_pk_fma_f32 v[52:53], v[68:69], v[30:31], v[52:53] op_sel_hi:[1,0,1]
    v_pk_fma_f32 v[54:55], v[70:71], v[30:31], v[54:55] op_sel_hi:[1,0,1]
    s_cbranch_scc1 L_hm2
    v_rcp_f32 v30, v29
    v_log_f32 v26, v29
    s_bfe_u32 s72, s31, 0x80008
    s_mul_i32 s72, s72, 5120
    s_add_u32 s58, s18, s72
    s_addc_u32 s59, s19, 0
    v_lshlrev_b32 v24, 9, v7
    v_lshl_add_u32 v24, v5, 4, v24
    v_lshlrev_b32 v25, 7, v7
    v_add_u32 v25, 4096, v25
    v_add_f32 v26, v26, v28
    v_mov_b32 v27, s75
    v_mov_b32 v6, 0xffffff00
    s_lshl_b32 s72, s37, 3
    s_lshl_b64 s[56:57], 0xff, s72
    s_cmp_eq_u32 s37, 8
    s_cselect_b64 exec, -1, s[56:57]
    v_pk_mul_f32 v[40:41], v[40:41], v[30:31] op_sel_hi:[1,0]
    v_pk_mul_f32 v[42:43], v[42:43], v[30:31] op_sel_hi:[1,0]
    v_and_or_b32 v40, v40, v6, s84
    v_and_or_b32 v41, v41, v6, s85
    v_and_or_b32 v42, v42, v6, s86
    v_and_or_b32 v43, v43, v6, s87
    v_pk_mul_f32 v[44:45], v[44:45], v[30:31] op_sel_hi:[1,0]
    v_pk_mul_f32 v[46:47], v[46:47], v[30:31] op_sel_hi:[1,0]
    v_and_or_b32 v44, v44, v6, s84
    v_and_or_b32 v45, v45, v6, s85
    v_and_or_b32 v46, v46, v6, s86
    v_and_or_b32 v47, v47, v6, s87
    v_pk_mul_f32 v[48:49], v[48:49], v[30:31] op_sel_hi:[1,0]
    v_pk_mul_f32 v[50:51], v[50:51], v[30:31] op_sel_hi:[1,0]
    v_and_or_b32 v48, v48, v6, s84
    v_and_or_b32 v49, v49, v6, s85
    v_and_or_b32 v50, v50, v6, s86
    v_and_or_b32 v51, v51, v6, s87
    v_pk_mul_f32 v[52:53], v[52:53], v[30:31] op_sel_hi:[1,0]
    v_pk_mul_f32 v[54:55], v[54:55], v[30:31] op_sel_hi:[1,0]
    v_and_or_b32 v52, v52, v6, s84
    v_and_or_b32 v53, v53, v6, s85
    v_and_or_b32 v54, v54, v6, s86
    v_and_or_b32 v55, v55, v6, s87
    s_bitcmp1_b32 s79, 28
    s_cbranch_scc0 L_pubfar
    global_store_dwordx4 v24, v[40:43], s[58:59] offset:0
    global_store_dwordx4 v24, v[44:47], s[58:59] offset:128
    global_store_dwordx4 v24, v[48:51], s[58:59] offset:256
    global_store_dwordx4 v24, v[52:55], s[58:59] offset:384
    s_and_b32 exec_lo, exec_lo, 0x01010101
    s_and_b32 exec_hi, exec_hi, 0x01010101
    global_store_dwordx2 v25, v[26:27], s[58:59]
    s_branch L_pubdone
L_pubfar:
    s_mov_b64 s[56:57], exec
    s_mov_b64 exec, -1
    s_cmp_eq_u32 s40, 0
    s_cbranch_scc1 L_fgo
L_fwait:
    ds_read_b32 v6, v33 offset:8
    s_waitcnt lgkmcnt(0)
    v_readfirstlane_b32 s72, v6
    s_nop 0
    s_cmp_eq_u32 s72, 0
    s_cbranch_scc1 L_fwait
L_fgo:
    s_mov_b64 exec, s[56:57]
    global_store_dwordx4 v24, v[40:43], s[58:59] offset:0 sc1 nt
    global_store_dwordx4 v24, v[44:47], s[58:59] offset:128 sc1 nt
    global_store_dwordx4 v24, v[48:51], s[58:59] offset:256 sc1 nt
    global_store_dwordx4 v24, v[52:55], s[58:59] offset:384 sc1 nt
    s_and_b32 exec_lo, exec_lo, 0x01010101
    s_and_b32 exec_hi, exec_hi, 0x01010101
    global_store_dwordx2 v25, v[26:27], s[58:59] sc1 nt
L_pubdone:
    s_mov_b64 exec, -1
    v_mov_b32 v28, s47
    v_mov_b32 v29, 0
    s_nop 0
    v_mov_b64 v[40:41], 0
    v_mov_b64 v[42:43], 0
L_hgather:
    s_cmp_eq_u32 s40, 0
    s_cbranch_scc1 L_hfinal
    ds_read_b32 v6, v33 offset:8
    s_waitcnt lgkmcnt(0)
    v_readfirstlane_b32 s72, v6
    s_nop 0
    s_cmp_lg_u32 s72, 2
    s_cbranch_scc1 L_hgather
    s_bfe_u32 s72, s31, 0x80010
    s_mul_i32 s72, s72, 5120
    s_add_u32 s58, s18, s72
    s_addc_u32 s59, s19, 0
    v_lshrrev_b32 v5, 5, v1
    v_mul_u32_u24 v5, 5120, v5
    v_and_b32 v7, 31, v1
    s_lshl_b32 s72, s33, 9
    s_lshl_b32 s73, s33, 7
    s_add_u32 s73, s73, 4096
    v_lshl_add_u32 v8, v7, 4, v5
    v_add_u32 v8, s72, v8
    v_add_u32 v9, s73, v5
    v_add_u32 v10, 10240, v8
    v_add_u32 v11, 10240, v9
    v_add_u32 v12, 20480, v8
    v_add_u32 v13, 20480, v9
    v_add_u32 v14, 30720, v8
    v_add_u32 v15, 30720, v9
    v_add_u32 v16, 40960, v8
    v_add_u32 v17, 40960, v9
    s_mov_b32 s73, 0
    s_waitcnt vmcnt(0)
    v_mov_b32 v82, s84
    v_mov_b32 v83, s85
    v_mov_b32 v84, s86
    v_mov_b32 v85, s87
    v_mov_b32 v86, s47
    v_mov_b32 v87, s75
    v_mov_b32 v88, s84
    v_mov_b32 v89, s85
    v_mov_b32 v90, s86
    v_mov_b32 v91, s87
    v_mov_b32 v92, s47
    v_mov_b32 v93, s75
    v_mov_b32 v94, s84
    v_mov_b32 v95, s85
    v_mov_b32 v96, s86
    v_mov_b32 v97, s87
    v_mov_b32 v98, s47
    v_mov_b32 v99, s75
    v_mov_b32 v100, s84
    v_mov_b32 v101, s85
    v_mov_b32 v102, s86
    v_mov_b32 v103, s87
    v_mov_b32 v104, s47
    v_mov_b32 v105, s75
L_gload:
    global_load_dwordx4 v[76:79], v8, s[58:59] sc1 nt
    global_load_dwordx2 v[80:81], v9, s[58:59] sc1 nt
    s_cmp_gt_u32 s40, 3
    s_cselect_b32 exec_hi, -1, 0
    global_load_dwordx4 v[82:85], v10, s[58:59] sc1 nt
    global_load_dwordx2 v[86:87], v11, s[58:59] sc1 nt
    s_cmp_gt_u32 s40, 4
    s_cbranch_scc0 L_gwait
    s_cmp_gt_u32 s40, 5
    s_cselect_b32 exec_hi, -1, 0
    global_load_dwordx4 v[88:91], v12, s[58:59] sc1 nt
    global_load_dwordx2 v[92:93], v13, s[58:59] sc1 nt
    s_cmp_gt_u32 s40, 6
    s_cbranch_scc0 L_gwait
    s_cmp_gt_u32 s40, 7
    s_cselect_b32 exec_hi, -1, 0
    global_load_dwordx4 v[94:97], v14, s[58:59] sc1 nt
    global_load_dwordx2 v[98:99], v15, s[58:59] sc1 nt
    s_cmp_gt_u32 s40, 8
    s_cbranch_scc0 L_gwait
    s_cmp_gt_u32 s40, 9
    s_cselect_b32 exec_hi, -1, 0
    global_load_dwordx4 v[100:103], v16, s[58:59] sc1 nt
    global_load_dwordx2 v[104:105], v17, s[58:59] sc1 nt
L_gwait:
    s_mov_b64 exec, -1
    s_add_u32 s73, s73, 1
    v_mov_b32 v26, 0
    v_mov_b32 v27, 0
    s_waitcnt vmcnt(0)
    v_xor_b32 v56, s84, v76
    v_xor_b32 v57, s85, v77
    v_xor_b32 v58, s86, v78
    v_xor_b32 v59, s87, v79
    v_xor_b32 v60, s75, v81
    v_or3_b32 v26, v26, v56, v57
    v_or3_b32 v26, v26, v58, v59
    v_or_b32 v27, v27, v60
    v_xor_b32 v56, s84, v82
    v_xor_b32 v57, s85, v83
    v_xor_b32 v58, s86, v84
    v_xor_b32 v59, s87, v85
    v_xor_b32 v60, s75, v87
    v_or3_b32 v26, v26, v56, v57
    v_or3_b32 v26, v26, v58, v59
    v_or_b32 v27, v27, v60
    v_xor_b32 v56, s84, v88
    v_xor_b32 v57, s85, v89
    v_xor_b32 v58, s86, v90
    v_xor_b32 v59, s87, v91
    v_xor_b32 v60, s75, v93
    v_or3_b32 v26, v26, v56, v57
    v_or3_b32 v26, v26, v58, v59
    v_or_b32 v27, v27, v60
    v_xor_b32 v56, s84, v94
    v_xor_b32 v57, s85, v95
    v_xor_b32 v58, s86, v96
    v_xor_b32 v59, s87, v97
    v_xor_b32 v60, s75, v99
    v_or3_b32 v26, v26, v56, v57
    v_or3_b32 v26, v26, v58, v59
    v_or_b32 v27, v27, v60
    v_xor_b32 v56, s84, v100
    v_xor_b32 v57, s85, v101
    v_xor_b32 v58, s86, v102
    v_xor_b32 v59, s87, v103
    v_xor_b32 v60, s75, v105
    v_or3_b32 v26, v26, v56, v57
    v_or3_b32 v26, v26, v58, v59
    v_or_b32 v27, v27, v60
    v_and_b32 v26, 0xff, v26
    v_or_b32 v27, v27, v26
    v_cmp_ne_u32 vcc, 0, v27
    s_cmp_gt_u32 s73, 0x100000
    s_cbranch_scc1 L_gdone
    s_cbranch_vccz L_gdone
    s_branch L_gload
L_gdone:
    v_and_b32 v76, 0xffffff00, v76
    v_and_b32 v77, 0xffffff00, v77
    v_and_b32 v78, 0xffffff00, v78
    v_and_b32 v79, 0xffffff00, v79
    v_and_b32 v82, 0xffffff00, v82
    v_and_b32 v83, 0xffffff00, v83
    v_and_b32 v84, 0xffffff00, v84
    v_and_b32 v85, 0xffffff00, v85
    v_and_b32 v88, 0xffffff00, v88
    v_and_b32 v89, 0xffffff00, v89
    v_and_b32 v90, 0xffffff00, v90
    v_and_b32 v91, 0xffffff00, v91
    v_and_b32 v94, 0xffffff00, v94
    v_and_b32 v95, 0xffffff00, v95
    v_and_b32 v96, 0xffffff00, v96
    v_and_b32 v97, 0xffffff00, v97
    v_and_b32 v100, 0xffffff00, v100
    v_and_b32 v101, 0xffffff00, v101
    v_and_b32 v102, 0xffffff00, v102
    v_and_b32 v103, 0xffffff00, v103
    v_mov_b32 v6, v28
    v_max3_f32 v28, v28, v80, v86
    v_max3_f32 v28, v28, v92, v98
    v_max_f32 v28, v28, v104
    v_sub_f32 v30, v6, v28
    v_sub_f32 v80, v80, v28
    v_sub_f32 v86, v86, v28
    v_sub_f32 v92, v92, v28
    v_sub_f32 v98, v98, v28
    v_sub_f32 v104, v104, v28
    v_exp_f32 v30, v30
    v_exp_f32 v80, v80
    v_exp_f32 v86, v86
    v_exp_f32 v92, v92
    v_exp_f32 v98, v98
    v_exp_f32 v104, v104
    v_mul_f32 v29, v30, v29
    v_pk_mul_f32 v[40:41], v[40:41], v[30:31] op_sel_hi:[1,0]
    v_pk_mul_f32 v[42:43], v[42:43], v[30:31] op_sel_hi:[1,0]
    v_add_f32 v29, v80, v29
    v_pk_fma_f32 v[40:41], v[76:77], v[80:81], v[40:41] op_sel_hi:[1,0,1]
    v_pk_fma_f32 v[42:43], v[78:79], v[80:81], v[42:43] op_sel_hi:[1,0,1]
    v_add_f32 v29, v86, v29
    v_pk_fma_f32 v[40:41], v[82:83], v[86:87], v[40:41] op_sel_hi:[1,0,1]
    v_pk_fma_f32 v[42:43], v[84:85], v[86:87], v[42:43] op_sel_hi:[1,0,1]
    v_add_f32 v29, v92, v29
    v_pk_fma_f32 v[40:41], v[88:89], v[92:93], v[40:41] op_sel_hi:[1,0,1]
    v_pk_fma_f32 v[42:43], v[90:91], v[92:93], v[42:43] op_sel_hi:[1,0,1]
    v_add_f32 v29, v98, v29
    v_pk_fma_f32 v[40:41], v[94:95], v[98:99], v[40:41] op_sel_hi:[1,0,1]
    v_pk_fma_f32 v[42:43], v[96:97], v[98:99], v[42:43] op_sel_hi:[1,0,1]
    v_add_f32 v29, v104, v29
    v_pk_fma_f32 v[40:41], v[100:101], v[104:105], v[40:41] op_sel_hi:[1,0,1]
    v_pk_fma_f32 v[42:43], v[102:103], v[104:105], v[42:43] op_sel_hi:[1,0,1]
L_hfinal:
    v_lshrrev_b32 v5, 5, v1
    v_mul_u32_u24 v25, 528, v5
    v_and_b32 v7, 31, v1
    v_lshl_add_u32 v24, v7, 4, v25
    s_lshl_b32 s72, s33, 5
    s_add_u32 s72, s72, s34
    s_lshl_b32 s72, s72, 8
    v_lshl_add_u32 v26, v7, 3, s72
    v_lshl_add_u32 v26, v5, 2, v26
    s_barrier
    ds_read_b64 v[80:81], v25 offset:4864
    ds_read_b64 v[86:87], v25 offset:5920
    ds_read_b128 v[76:79], v24 offset:4352
    ds_read_b128 v[82:85], v24 offset:5408
    s_waitcnt lgkmcnt(2)
    v_mov_b32 v6, v28
    v_max3_f32 v28, v28, v80, v86
    v_mov_b32 v30, v28
    s_nop 1
    v_permlane32_swap_b32 v28, v30
    v_max_f32 v28, v28, v30
    v_sub_f32 v30, v6, v28
    v_sub_f32 v80, v80, v28
    v_sub_f32 v86, v86, v28
    v_exp_f32 v30, v30
    v_exp_f32 v80, v80
    v_exp_f32 v86, v86
    v_mul_f32 v29, v30, v29
    v_pk_mul_f32 v[40:41], v[40:41], v[30:31] op_sel_hi:[1,0]
    v_pk_mul_f32 v[42:43], v[42:43], v[30:31] op_sel_hi:[1,0]
    s_waitcnt lgkmcnt(0)
    v_fma_f32 v29, v80, v81, v29
    v_pk_fma_f32 v[40:41], v[76:77], v[80:81], v[40:41] op_sel_hi:[1,0,1]
    v_pk_fma_f32 v[42:43], v[78:79], v[80:81], v[42:43] op_sel_hi:[1,0,1]
    v_fma_f32 v29, v86, v87, v29
    v_pk_fma_f32 v[40:41], v[82:83], v[86:87], v[40:41] op_sel_hi:[1,0,1]
    v_pk_fma_f32 v[42:43], v[84:85], v[86:87], v[42:43] op_sel_hi:[1,0,1]
    v_mov_b32 v30, v29
    s_nop 1
    v_permlane32_swap_b32 v29, v30
    v_permlane32_swap_b32 v40, v42
    v_permlane32_swap_b32 v41, v43
    v_add_f32 v29, v29, v30
    v_rcp_f32 v30, v29
    v_pk_add_f32 v[40:41], v[40:41], v[42:43]
    v_pk_mul_f32 v[40:41], v[40:41], v[30:31] op_sel_hi:[1,0]
    v_cvt_pk_bf16_f32 v27, v40, v41
    global_store_dword v26, v27, s[14:15]
L_end:
    s_endpgm
L_alone:
    s_sub_u32 s70, s35, 4
    v_mov_b32 v31, s70
    v_mad_u32_u24 v31, v1, 4, v31
    s_lshr_b32 s71, s30, 23
    s_add_u32 s71, s71, s36
    s_add_u32 s71, s71, s38
    v_subrev_u32 v42, s38, v31
    s_lshl_b32 s72, s33, 6
    v_add_u32 v43, s72, v42
    v_cmp_gt_u32 vcc, 64, v42
    v_cmp_gt_u32 s[48:49], s71, v31
    s_lshl_b32 s73, s34, 8
    v_cndmask_b32 v43, v43, v42, vcc
    v_cmp_le_u32 vcc, s38, v31
    v_lshl_add_u32 v43, v43, 17, s73
    v_lshlrev_b32 v42, 4, v42
    s_bcnt1_i32_b64 s69, s[48:49]
    v_cndmask_b32 v24, v24, v43, vcc
    v_cndmask_b32 v25, v25, v42, vcc
    s_add_u32 s69, s69, 1
    s_mov_b32 s74, -1
    s_branch L_back0
L_general:
    v_and_b32 v42, 7, v1
    v_lshlrev_b32 v42, 2, v42
    ds_read_b32 v43, v42 offset:32
    v_mov_b32 v31, s35
    v_mad_u32_u24 v31, v1, 4, v31
    v_min_u32 v42, 127, v31
    s_lshl_b32 s72, s33, 9
    v_lshl_add_u32 v42, v42, 2, s72
    global_load_dword v44, v42, s[10:11]
    v_lshlrev_b32 v45, 2, v2
    s_waitcnt lgkmcnt(0)
    v_readlane_b32 s70, v43, s33
    v_sub_u32 v26, v43, v45
    v_lshlrev_b32 v25, 4, v31
    s_min_i32 s71, s70, 2048
    s_add_u32 s71, s71, 15
    s_lshr_b32 s71, s71, 4
    s_cmp_gt_i32 s70, 0
    s_cselect_b32 s71, s71, 128
    v_cmp_gt_u32 vcc, s71, v31
    s_mov_b32 s83, -1
    s_mov_b32 s82, -1
    s_mov_b32 s41, 0
    s_mov_b32 s74, -1
    s_bcnt1_i32_b64 s69, vcc
    v_mov_b32 v28, s47
    v_mov_b32 v29, 0
    v_mov_b64 v[112:113], 0
    v_mov_b64 v[114:115], 0
    v_mov_b64 v[116:117], 0
    v_mov_b64 v[118:119], 0
    v_mov_b64 v[120:121], 0
    v_mov_b64 v[122:123], 0
    v_mov_b64 v[124:125], 0
    v_mov_b64 v[126:127], 0
    v_mov_b64 v[128:129], 0
    v_mov_b64 v[130:131], 0
    v_mov_b64 v[132:133], 0
    v_mov_b64 v[134:135], 0
    v_mov_b64 v[136:137], 0
    v_mov_b64 v[138:139], 0
    v_mov_b64 v[140:141], 0
    v_mov_b64 v[142:143], 0
    v_mov_b64 v[184:185], v[28:29]
    s_mov_b64 s[96:97], s[98:99]
    v_mov_b64 v[48:49], v[64:65]
    v_mov_b64 v[50:51], v[66:67]
    v_mov_b64 v[52:53], v[68:69]
    v_mov_b64 v[54:55], v[70:71]
    v_mov_b64 v[56:57], v[72:73]
    v_mov_b64 v[58:59], v[74:75]
    v_mov_b64 v[60:61], v[76:77]
    v_mov_b64 v[62:63], v[78:79]
    s_lshl_b32 s73, s34, 8
    v_mov_b32 v46, 1
    s_waitcnt vmcnt(0)
    v_add_u32 v45, 576, v44
    v_cmp_gt_i32 vcc, 0, v44
    s_barrier
    ds_write_b32 v33, v46 offset:0
    v_cndmask_b32 v44, v44, v45, vcc
    v_min_u32 v44, 575, v44
    v_lshl_add_u32 v24, v44, 17, s73
    s_waitcnt lgkmcnt(0)
    s_cmp_eq_u32 s69, 0
    s_cbranch_scc1 L_final
    v_readfirstlane_b32 s43, v24
    s_mov_b32 m0, s45
    s_nop 4
    buffer_load_dwordx4 v4, s[20:23], s43 offen offset:0 nt lds
    buffer_load_dwordx4 v5, s[20:23], s43 offen offset:1024 nt lds
    buffer_load_dwordx4 v6, s[20:23], s43 offen offset:2048 nt lds
    buffer_load_dwordx4 v7, s[20:23], s43 offen offset:3072 nt lds
    s_add_u32 m0, s45, 4096
    s_nop 0
    buffer_load_dwordx4 v8, s[24:27], s43 offen offset:0 nt lds
    buffer_load_dwordx4 v9, s[24:27], s43 offen offset:1024 nt lds
    buffer_load_dwordx4 v10, s[24:27], s43 offen offset:2048 nt lds
    buffer_load_dwordx4 v11, s[24:27], s43 offen offset:3072 nt lds
    s_branch L_tile
.p2align 9
.type L_table,@object
L_table:
    .long 0x00260100, 0x005a0000, 0x16938693, 0x13000508
    .long 0x00360000, 0x00d60000, 0x159b8775, 0x13000101
    .long 0x02801500, 0x01680000, 0x1a4046ec, 0x030070aa
    .long 0x02001900, 0x01f40000, 0x1d4036ca, 0x040087cb
    .long 0x006e0100, 0x02760000, 0x1db78745, 0x1300070c
    .long 0x031e0100, 0x02fe0000, 0x1fcf5761, 0x13000a0d
    .long 0x00000000, 0x034a0000, 0x1280875b, 0x13000006
    .long 0x004c0100, 0x03de0000, 0x17a686b1, 0x1300060f
    .long 0x00641200, 0x00660100, 0x19b285cd, 0x15045d90
    .long 0x00780100, 0x00f80100, 0x1e3c8544, 0x15040809
    .long 0x00000100, 0x01800100, 0x20008560, 0x0504000a
    .long 0x00000100, 0x020a0100, 0x22808560, 0x0604000b
    .long 0x00000100, 0x02940100, 0x25008560, 0x0604000c
    .long 0x007e1200, 0x031e0100, 0x27bf8561, 0x17045e95
    .long 0x00600000, 0x03600100, 0x183085f0, 0x15040206
    .long 0x02000000, 0x03f80100, 0x1e403504, 0x15040307
    .long 0x00000100, 0x005a1200, 0x16808693, 0x145b0408
    .long 0x03001100, 0x00e01200, 0x184056d0, 0x045b5989
    .long 0x02801100, 0x01681200, 0x1a4046ec, 0x045b598a
    .long 0x02001d00, 0x01f41200, 0x1d4036ca, 0x055b9beb
    .long 0x02000100, 0x02761200, 0x1dc03745, 0x145b090c
    .long 0x00001200, 0x03001200, 0x20008740, 0x045b0095
    .long 0x00001200, 0x034a1200, 0x1280875b, 0x145b5b96
    .long 0x00361200, 0x03d21200, 0x149b8777, 0x145b5c97
    .long 0x00361300, 0x004c1300, 0x131b877a, 0x13606198
    .long 0x03001d00, 0x00e01300, 0x184056d0, 0x03609be9
    .long 0x02801d00, 0x016a1300, 0x1ac046cb, 0x03609bea
    .long 0x006a1300, 0x01ea1300, 0x1ab5876b, 0x1360629b
    .long 0x02001200, 0x02781300, 0x1e403724, 0x13605f94
    .long 0x00001300, 0x03001300, 0x20008740, 0x0360009d
    .long 0x00001300, 0x034a1300, 0x1280875b, 0x1360609e
    .long 0x03001900, 0x03de1300, 0x17c056b1, 0x036087cf
    .long 0x002e0200, 0x00580200, 0x161786b5, 0x140b0c10
    .long 0x00321100, 0x00ea0200, 0x1a99862b, 0x130b5489
    .long 0x03001000, 0x016c0200, 0x1b4056aa, 0x130b5182
    .long 0x03001400, 0x01f40200, 0x1d4056c6, 0x030b67a3
    .long 0x02981100, 0x02800200, 0x204c46a1, 0x140b5a8c
    .long 0x00000200, 0x03080200, 0x220086c0, 0x040b0015
    .long 0x00000200, 0x03520200, 0x148086d7, 0x130b0b16
    .long 0x00001100, 0x03e60200, 0x1980862d, 0x130b528f
    .long 0x00580200, 0x00580300, 0x162c86b4, 0x130f0d10
    .long 0x001a1100, 0x00e80300, 0x1a0d864c, 0x130f5389
    .long 0x00681100, 0x01700300, 0x1c348668, 0x130f578a
    .long 0x03000300, 0x01f60300, 0x1dc056a5, 0x130f121b
    .long 0x02800200, 0x027e0300, 0x1fc046c1, 0x130f0e14
    .long 0x00000300, 0x030a0300, 0x228086a0, 0x040f001d
    .long 0x00000300, 0x03520300, 0x148086d7, 0x130f0f1e
    .long 0x005c0300, 0x03dc0300, 0x172e86d2, 0x130f111f
    .long 0x00001000, 0x00561000, 0x158086d5, 0x144d4d80
    .long 0x004e1000, 0x00e01000, 0x182786d0, 0x144d4f81
    .long 0x00581100, 0x01701000, 0x1c2c8668, 0x144d568a
    .long 0x01801100, 0x01f81000, 0x1e402684, 0x144d598b
    .long 0x00800200, 0x027e1000, 0x1fc006c1, 0x144d0e14
    .long 0x00781100, 0x030c1000, 0x233c8684, 0x154d588d
    .long 0x002e0300, 0x03521000, 0x149786d7, 0x144d101e
    .long 0x002a1000, 0x03dc1000, 0x171586d2, 0x144d4e87
    .long 0x006e1000, 0x006e1100, 0x1bb78549, 0x17525080
    .long 0x03201100, 0x00fc1100, 0x1f505502, 0x17525a89
    .long 0x00001100, 0x01881100, 0x220084e0, 0x0852008a
    .long 0x00001100, 0x02101100, 0x24008500, 0x0852008b
    .long 0x00001100, 0x029a1100, 0x26808500, 0x0952008c
    .long 0x00001100, 0x03241100, 0x29008500, 0x0952008d
    .long 0x00481100, 0x03701100, 0x1c2484e8, 0x1752558e
    .long 0x03000200, 0x03f81100, 0x1e405504, 0x17520e17
    .long 0x00000500, 0x005c0400, 0x17008672, 0x13131628
    .long 0x03000100, 0x00e20400, 0x18c056af, 0x03130909
    .long 0x006c0500, 0x016c0400, 0x1b3686aa, 0x1313192a
    .long 0x02001100, 0x01f00400, 0x1c403708, 0x0313598b
    .long 0x02900500, 0x027a0400, 0x1ec84703, 0x13131b2c
    .long 0x00000400, 0x03000400, 0x20008740, 0x03130025
    .long 0x00000400, 0x034a0400, 0x1280875b, 0x13131326
    .long 0x00360400, 0x03d40400, 0x151b8756, 0x13131427
    .long 0x02800500, 0x00700500, 0x1c404528, 0x14161a28
    .long 0x00741700, 0x00f40500, 0x1d3a8586, 0x141679b9
    .long 0x00000500, 0x01800500, 0x20008560, 0x0416002a
    .long 0x00000500, 0x020e0500, 0x23808520, 0x0516002b
    .long 0x00000500, 0x02960500, 0x25808540, 0x0616002c
    .long 0x00000500, 0x031e0500, 0x27808560, 0x0516002d
    .long 0x00620400, 0x03620500, 0x18b185cf, 0x14161526
    .long 0x00641700, 0x03f00500, 0x1c328588, 0x141678bf
    .long 0x00321700, 0x004e1600, 0x13998759, 0x137277b8
    .long 0x03000900, 0x00e21600, 0x18c056af, 0x03722e49
    .long 0x03001c00, 0x01621600, 0x18c0574f, 0x037293e2
    .long 0x006c1600, 0x01ec1600, 0x1b36874a, 0x137274b3
    .long 0x04001600, 0x02781600, 0x1e407724, 0x137275b4
    .long 0x00001600, 0x03001600, 0x20008740, 0x037200b5
    .long 0x00001600, 0x034a1600, 0x1280875b, 0x137272b6
    .long 0x00480500, 0x03e41600, 0x19248652, 0x1472182f
    .long 0x00001700, 0x004e1700, 0x13808759, 0x147676b8
    .long 0x03001500, 0x00e21700, 0x18c056af, 0x047670a9
    .long 0x02800900, 0x016a1700, 0x1ac046cb, 0x04762e4a
    .long 0x02000500, 0x01f21700, 0x1cc036e7, 0x14761a2b
    .long 0x04001700, 0x02781700, 0x1e407724, 0x14767abc
    .long 0x00001700, 0x03001700, 0x20008740, 0x047600bd
    .long 0x00361600, 0x034a1700, 0x129b875b, 0x147673b6
    .long 0x00240500, 0x03e41700, 0x19128652, 0x1576172f
    .long 0x00580600, 0x00580600, 0x162c86b4, 0x131c1e30
    .long 0x002c1500, 0x00ea0600, 0x1a96862b, 0x131c6aa9
    .long 0x00621500, 0x01700600, 0x1c318668, 0x131c6daa
    .long 0x03000600, 0x01f60600, 0x1dc056a5, 0x131c1f33
    .long 0x00000600, 0x02800600, 0x200086a0, 0x031c0034
    .long 0x00000600, 0x030a0600, 0x228086a0, 0x041c0035
    .long 0x00000600, 0x03540600, 0x150086b6, 0x131c1c36
    .long 0x004a1400, 0x03de0600, 0x17a586b1, 0x131c65a7
    .long 0x002c0700, 0x00580700, 0x161686b4, 0x14202138
    .long 0x00161500, 0x00ea0700, 0x1a8b862b, 0x142069a9
    .long 0x00521500, 0x01700700, 0x1c298668, 0x14206caa
    .long 0x00760700, 0x01f60700, 0x1dbb86a5, 0x1420233b
    .long 0x00000700, 0x02800700, 0x200086a0, 0x0420003c
    .long 0x00000700, 0x030a0700, 0x228086a0, 0x0520003d
    .long 0x002c0600, 0x03540700, 0x151686b6, 0x14201d36
    .long 0x00540700, 0x03de0700, 0x17aa86b1, 0x1420223f
    .long 0x00001400, 0x00581400, 0x160086b4, 0x146363a0
    .long 0x00001500, 0x00ea1400, 0x1a80862b, 0x146368a9
    .long 0x006c1400, 0x016c1400, 0x1b3686aa, 0x146366a2
    .long 0x03000700, 0x01f61400, 0x1dc056a5, 0x1463243b
    .long 0x00001400, 0x02801400, 0x200086a0, 0x046300a4
    .long 0x007e1500, 0x030a1400, 0x22bf86a1, 0x15636fad
    .long 0x00000700, 0x03541400, 0x150086b6, 0x1463203e
    .long 0x00281400, 0x03de1400, 0x179486b1, 0x146364a7
    .long 0x00721500, 0x00741500, 0x1d3984e6, 0x18686ea8
    .long 0x02981500, 0x00fe1500, 0x1fcc44e1, 0x186871a9
    .long 0x00001500, 0x01861500, 0x21808500, 0x096800aa
    .long 0x00001500, 0x02121500, 0x248084e0, 0x096800ab
    .long 0x00001500, 0x029a1500, 0x26808500, 0x0a6800ac
    .long 0x00001500, 0x03241500, 0x29008500, 0x0a6800ad
    .long 0x00421500, 0x03701500, 0x1c2184e8, 0x18686bae
    .long 0x031e1500, 0x03fa1500, 0x1ecf54e3, 0x186871af
    .long 0x00360800, 0x004e0800, 0x139b8759, 0x13252640
    .long 0x03000500, 0x00e20800, 0x18c056af, 0x03251a29
    .long 0x03001800, 0x01620800, 0x18c0574f, 0x03257fc2
    .long 0x02001500, 0x01f60800, 0x1dc036a9, 0x042570ab
    .long 0x031e0900, 0x027a0800, 0x1ecf5703, 0x13252f4c
    .long 0x00000800, 0x03000800, 0x20008740, 0x03250045
    .long 0x00000800, 0x034a0800, 0x1280875b, 0x13252546
    .long 0x00480900, 0x03e00800, 0x18248690, 0x13252b4f
    .long 0x00680800, 0x00680900, 0x1a3485ac, 0x15292740
    .long 0x01801d00, 0x00f80900, 0x1e402544, 0x05299be9
    .long 0x00000900, 0x01840900, 0x21008520, 0x0629004a
    .long 0x00000900, 0x020c0900, 0x23008540, 0x0629004b
    .long 0x00000900, 0x02960900, 0x25808540, 0x0629004c
    .long 0x007e0900, 0x03220900, 0x28bf8521, 0x17292d4d
    .long 0x00621a00, 0x03620900, 0x18b185cf, 0x15298bd6
    .long 0x02000900, 0x03f40900, 0x1d403546, 0x15292e4f
    .long 0x00240900, 0x005c1a00, 0x17128672, 0x13892a48
    .long 0x03000d00, 0x00e21a00, 0x18c056af, 0x03894269
    .long 0x00680900, 0x016a1a00, 0x1ab486cb, 0x13892c4a
    .long 0x02000800, 0x01f81a00, 0x1e403684, 0x13892843
    .long 0x01800900, 0x027c1a00, 0x1f4026e2, 0x13892e4c
    .long 0x00001a00, 0x03001a00, 0x20008740, 0x038900d5
    .long 0x00001a00, 0x034a1a00, 0x1280875b, 0x138989d6
    .long 0x00361a00, 0x03d41a00, 0x151b8756, 0x13898ad7
    .long 0x00000900, 0x005c1b00, 0x17008672, 0x138c2948
    .long 0x02801900, 0x00e41b00, 0x1940468e, 0x038c87c9
    .long 0x00621b00, 0x01621b00, 0x18b1874f, 0x138c8eda
    .long 0x00001b00, 0x02001b00, 0x20008600, 0x038c00db
    .long 0x00001b00, 0x02801b00, 0x200086a0, 0x038c00dc
    .long 0x00001b00, 0x03001b00, 0x20008740, 0x038c00dd
    .long 0x00001b00, 0x034a1b00, 0x1280875b, 0x138c8cde
    .long 0x00361b00, 0x03d41b00, 0x151b8756, 0x138c8ddf
    .long 0x00580a00, 0x00580a00, 0x162c86b4, 0x13303250
    .long 0x00301900, 0x00ea0a00, 0x1a98862b, 0x133082c9
    .long 0x00641900, 0x01720a00, 0x1cb28647, 0x133085ca
    .long 0x03000a00, 0x01f60a00, 0x1dc056a5, 0x13303353
    .long 0x00000a00, 0x02800a00, 0x200086a0, 0x03300054
    .long 0x00000a00, 0x030a0a00, 0x228086a0, 0x04300055
    .long 0x00000a00, 0x03540a00, 0x150086b6, 0x13303056
    .long 0x004a1800, 0x03de0a00, 0x17a586b1, 0x13307dc7
    .long 0x002c0b00, 0x005a0b00, 0x16968693, 0x14343558
    .long 0x00520b00, 0x00e20b00, 0x18a986af, 0x14343659
    .long 0x00561900, 0x01720b00, 0x1cab8647, 0x143484ca
    .long 0x03000b00, 0x01f60b00, 0x1dc056a5, 0x1434385b
    .long 0x00000b00, 0x02800b00, 0x200086a0, 0x0434005c
    .long 0x00000b00, 0x030a0b00, 0x228086a0, 0x0534005d
    .long 0x002c0a00, 0x03540b00, 0x151686b6, 0x14343156
    .long 0x00001900, 0x03e80b00, 0x1a00860d, 0x153480cf
    .long 0x00001800, 0x00581800, 0x160086b4, 0x147b7bc0
    .long 0x001a1900, 0x00ea1800, 0x1a8d862b, 0x147b81c9
    .long 0x006c1800, 0x016c1800, 0x1b3686aa, 0x147b7ec2
    .long 0x01801900, 0x01f81800, 0x1e402684, 0x147b87cb
    .long 0x00001800, 0x02801800, 0x200086a0, 0x047b00c4
    .long 0x00721900, 0x03101800, 0x24398647, 0x157b86cd
    .long 0x00000b00, 0x03541800, 0x150086b6, 0x147b345e
    .long 0x00281800, 0x03de1800, 0x179486b1, 0x147b7cc7
    .long 0x00700b00, 0x00701900, 0x1c388528, 0x17803758
    .long 0x04000b00, 0x00fe1900, 0x1fc074e1, 0x17803859
    .long 0x00001900, 0x01881900, 0x220084e0, 0x088000ca
    .long 0x00001900, 0x02141900, 0x250084c0, 0x088000cb
    .long 0x00001900, 0x029c1900, 0x270084e0, 0x088000cc
    .long 0x00001900, 0x03261900, 0x298084e0, 0x098000cd
    .long 0x00461900, 0x03701900, 0x1c2384e8, 0x178083ce
    .long 0x03221900, 0x03fc1900, 0x1f5154c2, 0x178088cf
    .long 0x00360c00, 0x004c0c00, 0x131b877a, 0x13393a60
    .long 0x001e0d00, 0x00e20c00, 0x188f86af, 0x13393d69
    .long 0x005a0d00, 0x016a0c00, 0x1aad86cb, 0x13393f6a
    .long 0x006a0c00, 0x01ea0c00, 0x1ab5876b, 0x13393b63
    .long 0x02000d00, 0x02760c00, 0x1dc03745, 0x1339426c
    .long 0x02920d00, 0x02fe0c00, 0x1fc94761, 0x1339436d
    .long 0x00000c00, 0x034a0c00, 0x1280875b, 0x13393966
    .long 0x00241f00, 0x03dc0c00, 0x171286d2, 0x1339a1ff
    .long 0x02800100, 0x006c0d00, 0x1b40456a, 0x063c0908
    .long 0x02001f00, 0x00fa0d00, 0x1ec03523, 0x163ca4f9
    .long 0x00000d00, 0x01800d00, 0x20008560, 0x063c006a
    .long 0x00000d00, 0x020a0d00, 0x22808560, 0x073c006b
    .long 0x00000d00, 0x02940d00, 0x25008560, 0x083c006c
    .long 0x00000d00, 0x031e0d00, 0x27808560, 0x073c006d
    .long 0x003c0d00, 0x036a0d00, 0x1a9e854f, 0x173c3e6e
    .long 0x00700d00, 0x03f40d00, 0x1d388547, 0x173c406f
    .long 0x00361e00, 0x004c1e00, 0x131b877a, 0x139d9ef0
    .long 0x00000d00, 0x00e21e00, 0x188086af, 0x139d3c69
    .long 0x03001f00, 0x01661e00, 0x19c0570d, 0x139da4fa
    .long 0x006a1e00, 0x01ea1e00, 0x1ab5876b, 0x139d9ff3
    .long 0x03800d00, 0x02781e00, 0x1e406724, 0x139d426c
    .long 0x04000d00, 0x02fe1e00, 0x1fc07761, 0x139d426d
    .long 0x00001e00, 0x034a1e00, 0x1280875b, 0x139d9df6
    .long 0x00001f00, 0x03dc1e00, 0x170086d2, 0x139da0ff
    .long 0x00661f00, 0x00661f00, 0x19b385cd, 0x14a0a3f8
    .long 0x02801f00, 0x00f21f00, 0x1cc045a7, 0x14a0a4f9
    .long 0x01801500, 0x017a1f00, 0x1ec025c3, 0x04a070aa
    .long 0x00001f00, 0x02061f00, 0x218085a0, 0x05a000fb
    .long 0x00001f00, 0x028e1f00, 0x238085c0, 0x05a000fc
    .long 0x007e0d00, 0x03181f00, 0x263f85c1, 0x15a0416d
    .long 0x00481f00, 0x03621f00, 0x18a485cf, 0x14a0a2fe
    .long 0x02800d00, 0x03ee1f00, 0x1bc045a9, 0x14a0426f
    .long 0x00580e00, 0x00580e00, 0x162c86b4, 0x13444670
    .long 0x00301d00, 0x00ea0e00, 0x1a98862b, 0x134496e9
    .long 0x00641d00, 0x01720e00, 0x1cb28647, 0x134499ea
    .long 0x02961d00, 0x01fa0e00, 0x1ecb4663, 0x13449ceb
    .long 0x00000e00, 0x02800e00, 0x200086a0, 0x03440074
    .long 0x00000e00, 0x030a0e00, 0x228086a0, 0x04440075
    .long 0x00000e00, 0x03540e00, 0x150086b6, 0x13444476
    .long 0x004a1c00, 0x03de0e00, 0x17a586b1, 0x134491e7
    .long 0x002c0f00, 0x005a0f00, 0x16968693, 0x14484978
    .long 0x00520f00, 0x00e20f00, 0x18a986af, 0x14484a79
    .long 0x00561d00, 0x01720f00, 0x1cab8647, 0x144898ea
    .long 0x03000e00, 0x01f60f00, 0x1dc056a5, 0x14484773
    .long 0x00000f00, 0x02800f00, 0x200086a0, 0x0448007c
    .long 0x00000f00, 0x030a0f00, 0x228086a0, 0x0548007d
    .long 0x002c0e00, 0x03540f00, 0x151686b6, 0x14484576
    .long 0x00001d00, 0x03e80f00, 0x1a00860d, 0x154894ef
    .long 0x00001c00, 0x00581c00, 0x160086b4, 0x148f8fe0
    .long 0x001a1d00, 0x00ea1c00, 0x1a8d862b, 0x148f95e9
    .long 0x006c1c00, 0x016c1c00, 0x1b3686aa, 0x148f92e2
    .long 0x03000f00, 0x01f61c00, 0x1dc056a5, 0x148f4c7b
    .long 0x00001c00, 0x02801c00, 0x200086a0, 0x048f00e4
    .long 0x00721d00, 0x03101c00, 0x24398647, 0x158f9aed
    .long 0x00000f00, 0x03541c00, 0x150086b6, 0x148f487e
    .long 0x00281c00, 0x03de1c00, 0x179486b1, 0x148f90e7
    .long 0x00700f00, 0x00701d00, 0x1c388528, 0x17944b78
    .long 0x04000f00, 0x00fe1d00, 0x1fc074e1, 0x17944c79
    .long 0x00001d00, 0x01881d00, 0x220084e0, 0x089400ea
    .long 0x00001d00, 0x02141d00, 0x250084c0, 0x089400eb
    .long 0x00001d00, 0x029c1d00, 0x270084e0, 0x099400ec
    .long 0x00001d00, 0x03261d00, 0x298084e0, 0x099400ed
    .long 0x00461d00, 0x03701d00, 0x1c2384e8, 0x179497ee
    .long 0x03201d00, 0x03fa1d00, 0x1ed054e3, 0x17949cef
.size L_table, 4096
.fill 1024, 4, 0xbf810000
.section .rodata,"a"
.p2align 6
.amdhsa_kernel standalone__paged_block_table_kv_radixattention__sampling_kernel
  .amdhsa_next_free_vgpr 188
  .amdhsa_next_free_sgpr 100
  .amdhsa_accum_offset 188
  .amdhsa_group_segment_fixed_size 0
  .amdhsa_kernarg_size 64
  .amdhsa_user_sgpr_count 2
  .amdhsa_user_sgpr_kernarg_segment_ptr 1
  .amdhsa_system_sgpr_workgroup_id_x 1
.end_amdhsa_kernel
```
